```python
import torch

def _softmax(x, axis=-1):
    return torch.softmax(x, dim=axis)

def _gelu(x):
    return torch.nn.functional.gelu(x, approximate='tanh')

def _silu(x):
    return torch.nn.functional.silu(x)

def _sigmoid(x):
    return torch.sigmoid(x)

def _layernorm(x, axis=-1, eps=1e-05):
    m = x.mean(dim=axis, keepdim=True)
    v = x.var(dim=axis, keepdim=True, unbiased=False)
    return (x - m) / torch.sqrt(v + eps)

def _scatter_add(tgt, idx, src, axis=0):
    return tgt.clone().index_add_(axis, idx, src)

def _segment_sum(src, seg, n):
    out = torch.zeros((n,) + src.shape[1:], dtype=src.dtype)
    return out.index_add_(0, seg, src)

def _pad(x, pw):
    flat = tuple((v for pair in reversed(pw) for v in pair))
    return torch.nn.functional.pad(x, flat)
kernel_name = 'standalone__tree_speculative_verify_tree_attention_over_candidate_token_tree__decode'

def setup_inputs():

    _w = lambda a: (lambda t: t.to(torch.bfloat16) if t.is_floating_point() else t)(torch.as_tensor(a))
    B, Hq, Hkv, T, C, D = (1, 32, 32, 1, 16384, 128)
    tree_mask = torch.zeros((B, T, T), dtype=float)
    for b in range(B):
        parent = torch.zeros(T, dtype=torch.int64)
        for i in range(1, T):
            parent[i] = int(torch.randint(0, i, (1,)).item())
        for i in range(T):
            j = i
            tree_mask[b, i, j] = 1.0
            while j > 0:
                j = parent[j]
                tree_mask[b, i, j] = 1.0
    return {'q': _w((lambda *s: torch.randn(*s, dtype=torch.bfloat16) * 0.8)(B, Hq, T, D)), 'k_cache': _w((lambda *s: torch.randn(*s, dtype=torch.bfloat16) * 0.8)(B, Hkv, C, D)), 'v_cache': _w((lambda *s: torch.randn(*s, dtype=torch.bfloat16) * 0.05)(B, Hkv, C, D)), 'k_tree': _w((lambda *s: torch.randn(*s, dtype=torch.bfloat16) * 0.8)(B, Hkv, T, D)), 'v_tree': _w((lambda *s: torch.randn(*s, dtype=torch.bfloat16) * 0.05)(B, Hkv, T, D)), 'tree_mask': _w(tree_mask)}

def reference(q, k_cache, v_cache, k_tree, v_tree, tree_mask):
    B, Hq, T, D = q.shape
    Hkv, C = (k_cache.shape[1], k_cache.shape[2])
    rep = Hq // Hkv
    kc = (lambda x, n, axis: torch.repeat_interleave(x, n, dim=axis))(k_cache, rep, axis=1)
    vc = (lambda x, n, axis: torch.repeat_interleave(x, n, dim=axis))(v_cache, rep, axis=1)
    kt = (lambda x, n, axis: torch.repeat_interleave(x, n, dim=axis))(k_tree, rep, axis=1)
    vt = (lambda x, n, axis: torch.repeat_interleave(x, n, dim=axis))(v_tree, rep, axis=1)
    k = torch.concatenate([kc, kt], axis=2)
    v = torch.concatenate([vc, vt], axis=2)
    scale = D ** (-0.5)
    scores = torch.einsum('bhqd,bhkd->bhqk', q, k) * scale
    ctx_mask = torch.ones((B, 1, T, C), dtype=scores.dtype)
    tm = tree_mask[:, None, :, :].clone()
    full_mask = torch.concatenate([ctx_mask, tm], axis=-1)
    scores = scores + (1.0 - full_mask) * -1000000000.0
    p = _softmax(scores, axis=-1)
    return torch.einsum('bhqk,bhkd->bhqd', p, v)
```

```asm
; @launch grid=(256,1,1) block=(192,1,1) lds=86016
.amdgcn_target "amdgcn-amd-amdhsa--gfx950"
.text
.globl standalone__tree_speculative_verify_tree_attention_over_candidate_token_tree__decode_kernel
.p2align 8
.type standalone__tree_speculative_verify_tree_attention_over_candidate_token_tree__decode_kernel,@function
standalone__tree_speculative_verify_tree_attention_over_candidate_token_tree__decode_kernel:
    s_cmp_ge_u32 s2, 256
    s_cbranch_scc1 L_end
    s_load_dwordx2 s[24:25], s[0:1], 8
    s_load_dwordx2 s[28:29], s[0:1], 16
    s_load_dwordx2 s[4:5], s[0:1], 0
    v_lshrrev_b32 v2, 6, v0
    v_and_b32 v1, 63, v0
    s_lshr_b32 s23, s2, 3
    v_readfirstlane_b32 s22, v2
    s_add_u32 s36, s2, s23
    s_and_b32 s36, s36, 7
    v_lshlrev_b32 v36, 4, v1
    s_lshl_b32 s3, s23, 22
    v_add_u32 v33, s3, v36
    s_add_u32 s26, s3, 4194304
    s_mov_b32 s27, 0x20000
    s_mov_b32 s30, s26
    s_mov_b32 s31, 0x20000
    s_lshl_b32 s37, s22, 3
    s_add_u32 s37, s37, s36
    s_mul_i32 s59, s23, 16
    s_add_u32 s3, s37, s59
    s_and_b32 s3, s3, 1023
    s_cmp_lt_u32 s37, 1024
    s_cselect_b32 s3, s3, 1024
    s_lshl_b32 s3, s3, 12
    v_add_u32 v32, s3, v33
    s_lshl_b32 s35, s23, 8
    v_and_b32 v3, 15, v0
    v_lshlrev_b32 v3, 4, v3
    v_add_u32 v3, s35, v3
    s_waitcnt lgkmcnt(0)
    global_load_dwordx4 v[4:7], v3, s[4:5]
    buffer_load_dwordx4 v[44:47], v32, s[24:27], 0 offen offset:0 nt
    buffer_load_dwordx4 v[48:51], v32, s[24:27], 0 offen offset:1024 nt
    buffer_load_dwordx4 v[52:55], v32, s[24:27], 0 offen offset:2048 nt
    buffer_load_dwordx4 v[56:59], v32, s[24:27], 0 offen offset:3072 nt
    buffer_load_dwordx4 v[60:63], v32, s[28:31], 0 offen offset:0 nt
    buffer_load_dwordx4 v[64:67], v32, s[28:31], 0 offen offset:1024 nt
    buffer_load_dwordx4 v[68:71], v32, s[28:31], 0 offen offset:2048 nt
    buffer_load_dwordx4 v[72:75], v32, s[28:31], 0 offen offset:3072 nt
    s_load_dwordx4 s[8:11], s[0:1], 24
    s_load_dwordx4 s[12:15], s[0:1], 40
    s_load_dwordx4 s[16:19], s[0:1], 56
    s_add_u32 s35, s35, 524288
    v_mov_b32 v34, s35
    s_lshl_b32 s3, s23, 2
    v_mov_b32 v35, s3
    v_mov_b32 v8, 0x3e0293ee
    v_mov_b32 v15, 1
    v_mov_b32 v16, 0
    v_mov_b32 v17, 0
    v_mov_b32 v18, 0
    v_mov_b32 v19, 0
    v_mov_b32 v20, 0
    v_mov_b32 v21, 0
    v_mov_b32 v22, 0
    v_mov_b32 v23, 0
    v_mov_b32 v10, 0
    v_mov_b32 v9, 0xff800000
    s_mov_b32 s34, 0
    s_lshl_b32 s33, s36, 4
    s_or_b32 s33, s33, s22
    s_waitcnt lgkmcnt(0)
    s_cmp_gt_u32 s33, 1
    s_cbranch_scc1 L_loop
    s_cmp_eq_u32 s33, 0
    s_cbranch_scc1 L_tree
    s_lshl_b32 s35, s23, 13
    v_add_u32 v1, s35, v36
    v_add_u32 v2, 4096, v1
    global_store_dwordx4 v1, v[16:19], s[18:19] offset:1024 sc1
    global_store_dwordx4 v1, v[16:19], s[18:19] offset:2048 sc1
    global_store_dwordx4 v1, v[16:19], s[18:19] offset:3072 sc1
    global_store_dwordx4 v2, v[16:19], s[18:19] offset:0 sc1
    global_store_dwordx4 v2, v[16:19], s[18:19] offset:1024 sc1
    global_store_dwordx4 v2, v[16:19], s[18:19] offset:2048 sc1
    global_store_dwordx4 v2, v[16:19], s[18:19] offset:3072 sc1
    s_mov_b64 exec, 1
    global_store_dword v34, v16, s[18:19] sc1
    s_waitcnt vmcnt(0)
    global_store_dword v35, v15, s[16:17] sc1
    s_mov_b64 exec, -1
    s_branch L_loop
L_tree:
    global_load_dwordx4 v[24:27], v3, s[8:9]
    global_load_dwordx4 v[28:31], v3, s[10:11]
    v_mov_b32 v11, 0
    global_load_ushort v12, v11, s[12:13]
    s_waitcnt vmcnt(0)
    v_dot2c_f32_bf16 v11, v24, v4
    v_dot2c_f32_bf16 v11, v25, v5
    v_dot2c_f32_bf16 v11, v26, v6
    v_dot2c_f32_bf16 v11, v27, v7
    s_nop 2
    v_add_f32_dpp v11, v11, v11 row_ror:8 row_mask:0xf bank_mask:0xf
    s_nop 1
    v_add_f32_dpp v11, v11, v11 row_ror:4 row_mask:0xf bank_mask:0xf
    s_nop 1
    v_add_f32_dpp v11, v11, v11 row_ror:2 row_mask:0xf bank_mask:0xf
    s_nop 1
    v_add_f32_dpp v11, v11, v11 row_ror:1 row_mask:0xf bank_mask:0xf
    s_nop 1
    v_lshlrev_b32 v12, 16, v12
    v_sub_f32 v12, 1.0, v12
    v_mul_f32 v12, 0xceabfb8f, v12
    v_fma_f32 v9, v11, v8, v12
    s_mov_b64 exec, 0xffff
    v_mov_b32 v10, 1.0
    v_lshlrev_b32 v16, 16, v28
    v_and_b32 v17, 0xffff0000, v28
    v_lshlrev_b32 v18, 16, v29
    v_and_b32 v19, 0xffff0000, v29
    v_lshlrev_b32 v20, 16, v30
    v_and_b32 v21, 0xffff0000, v30
    v_lshlrev_b32 v22, 16, v31
    v_and_b32 v23, 0xffff0000, v31
    s_mov_b64 exec, -1
L_loop:
    s_waitcnt vmcnt(6)
    s_add_u32 s38, s37, 24
    s_cmp_lt_u32 s34, 33
    s_cbranch_scc1 L_addr
    v_readfirstlane_b32 s39, v14
    s_mov_b64 exec, 1
    s_cmp_ge_u32 s34, 35
    s_cbranch_scc1 L_dyn
    s_cmp_eq_u32 s34, 34
    s_cbranch_scc1 L_chk
L_flagld:
    global_load_dword v14, v35, s[16:17] sc1
    s_cmp_eq_u32 s34, 34
    s_cbranch_scc0 L_full
    s_waitcnt vmcnt(0)
    v_readfirstlane_b32 s39, v14
    s_nop 3
L_chk:
    s_cmp_eq_u32 s39, 0
    s_cbranch_scc1 L_flagld
    s_branch L_claim
L_dyn:
    s_add_u32 s38, s39, 864
L_claim:
    global_atomic_add v14, v34, v15, s[18:19] sc0
L_full:
    s_mov_b64 exec, -1
L_addr:
    s_add_u32 s3, s38, s59
    s_and_b32 s3, s3, 1023
    s_cmp_lt_u32 s38, 1024
    s_cselect_b32 s3, s3, 1024
    s_lshl_b32 s3, s3, 12
    v_add_u32 v32, s3, v33
L_body:
    v_mov_b32 v24, 0
    v_mov_b32 v25, 0
    v_dot2c_f32_bf16 v24, v44, v4
    v_dot2c_f32_bf16 v25, v48, v4
    v_dot2c_f32_bf16 v24, v45, v5
    v_dot2c_f32_bf16 v25, v49, v5
    v_dot2c_f32_bf16 v24, v46, v6
    v_dot2c_f32_bf16 v25, v50, v6
    v_dot2c_f32_bf16 v24, v47, v7
    v_dot2c_f32_bf16 v25, v51, v7
    buffer_load_dwordx4 v[44:47], v32, s[24:27], 0 offen offset:0 nt
    buffer_load_dwordx4 v[48:51], v32, s[24:27], 0 offen offset:1024 nt
    s_waitcnt vmcnt(6)
    v_mov_b32 v26, 0
    v_mov_b32 v27, 0
    v_dot2c_f32_bf16 v26, v52, v4
    v_dot2c_f32_bf16 v27, v56, v4
    v_dot2c_f32_bf16 v26, v53, v5
    v_dot2c_f32_bf16 v27, v57, v5
    v_dot2c_f32_bf16 v26, v54, v6
    v_dot2c_f32_bf16 v27, v58, v6
    v_dot2c_f32_bf16 v26, v55, v7
    v_dot2c_f32_bf16 v27, v59, v7
    buffer_load_dwordx4 v[52:55], v32, s[24:27], 0 offen offset:2048 nt
    buffer_load_dwordx4 v[56:59], v32, s[24:27], 0 offen offset:3072 nt
    s_nop 0
    v_add_f32_dpp v24, v24, v24 row_ror:8 row_mask:0xf bank_mask:0xf
    v_add_f32_dpp v25, v25, v25 row_ror:8 row_mask:0xf bank_mask:0xf
    v_add_f32_dpp v26, v26, v26 row_ror:8 row_mask:0xf bank_mask:0xf
    v_add_f32_dpp v27, v27, v27 row_ror:8 row_mask:0xf bank_mask:0xf
    v_add_f32_dpp v24, v24, v24 row_ror:4 row_mask:0xf bank_mask:0xf
    v_add_f32_dpp v25, v25, v25 row_ror:4 row_mask:0xf bank_mask:0xf
    v_add_f32_dpp v26, v26, v26 row_ror:4 row_mask:0xf bank_mask:0xf
    v_add_f32_dpp v27, v27, v27 row_ror:4 row_mask:0xf bank_mask:0xf
    v_add_f32_dpp v24, v24, v24 row_ror:2 row_mask:0xf bank_mask:0xf
    v_add_f32_dpp v25, v25, v25 row_ror:2 row_mask:0xf bank_mask:0xf
    v_add_f32_dpp v26, v26, v26 row_ror:2 row_mask:0xf bank_mask:0xf
    v_add_f32_dpp v27, v27, v27 row_ror:2 row_mask:0xf bank_mask:0xf
    v_add_f32_dpp v24, v24, v24 row_ror:1 row_mask:0xf bank_mask:0xf
    v_add_f32_dpp v25, v25, v25 row_ror:1 row_mask:0xf bank_mask:0xf
    v_add_f32_dpp v26, v26, v26 row_ror:1 row_mask:0xf bank_mask:0xf
    v_add_f32_dpp v27, v27, v27 row_ror:1 row_mask:0xf bank_mask:0xf
    v_max3_f32 v11, v24, v25, v26
    v_max_f32 v11, v11, v27
    s_nop 1
    v_max_f32_dpp v11, v11, v11 row_bcast:15 row_mask:0xa bank_mask:0xf
    s_nop 1
    v_max_f32_dpp v11, v11, v11 row_bcast:31 row_mask:0xc bank_mask:0xf
    s_nop 0
    v_readlane_b32 s40, v11, 63
    s_nop 1
    v_mul_f32 v11, s40, v8
    v_max_f32 v11, v11, v9
    v_sub_f32 v12, v9, v11
    v_exp_f32 v12, v12
    v_mov_b32 v9, v11
    v_fma_f32 v24, v24, v8, -v11
    v_fma_f32 v25, v25, v8, -v11
    v_fma_f32 v26, v26, v8, -v11
    v_fma_f32 v27, v27, v8, -v11
    v_exp_f32 v24, v24
    v_exp_f32 v25, v25
    v_exp_f32 v26, v26
    v_exp_f32 v27, v27
    v_mul_f32 v10, v10, v12
    v_mul_f32 v16, v16, v12
    v_mul_f32 v17, v17, v12
    v_mul_f32 v18, v18, v12
    v_mul_f32 v19, v19, v12
    v_mul_f32 v20, v20, v12
    v_mul_f32 v21, v21, v12
    v_mul_f32 v22, v22, v12
    v_mul_f32 v23, v23, v12
    v_add_f32 v10, v10, v24
    v_add_f32 v10, v10, v25
    v_add_f32 v10, v10, v26
    v_add_f32 v10, v10, v27
    v_cvt_pk_bf16_f32 v37, v24, 0
    v_cvt_pk_bf16_f32 v38, 0, v24
    v_cvt_pk_bf16_f32 v39, v25, 0
    v_cvt_pk_bf16_f32 v40, 0, v25
    s_waitcnt vmcnt(6)
    v_dot2c_f32_bf16 v16, v60, v37
    v_dot2c_f32_bf16 v17, v60, v38
    v_dot2c_f32_bf16 v18, v61, v37
    v_dot2c_f32_bf16 v19, v61, v38
    v_dot2c_f32_bf16 v20, v62, v37
    v_dot2c_f32_bf16 v21, v62, v38
    v_dot2c_f32_bf16 v22, v63, v37
    v_dot2c_f32_bf16 v23, v63, v38
    v_dot2c_f32_bf16 v16, v64, v39
    v_dot2c_f32_bf16 v17, v64, v40
    v_dot2c_f32_bf16 v18, v65, v39
    v_dot2c_f32_bf16 v19, v65, v40
    v_dot2c_f32_bf16 v20, v66, v39
    v_dot2c_f32_bf16 v21, v66, v40
    v_dot2c_f32_bf16 v22, v67, v39
    v_dot2c_f32_bf16 v23, v67, v40
    buffer_load_dwordx4 v[60:63], v32, s[28:31], 0 offen offset:0 nt
    buffer_load_dwordx4 v[64:67], v32, s[28:31], 0 offen offset:1024 nt
    v_cvt_pk_bf16_f32 v37, v26, 0
    v_cvt_pk_bf16_f32 v38, 0, v26
    v_cvt_pk_bf16_f32 v39, v27, 0
    v_cvt_pk_bf16_f32 v40, 0, v27
    s_waitcnt vmcnt(6)
    v_dot2c_f32_bf16 v16, v68, v37
    v_dot2c_f32_bf16 v17, v68, v38
    v_dot2c_f32_bf16 v18, v69, v37
    v_dot2c_f32_bf16 v19, v69, v38
    v_dot2c_f32_bf16 v20, v70, v37
    v_dot2c_f32_bf16 v21, v70, v38
    v_dot2c_f32_bf16 v22, v71, v37
    v_dot2c_f32_bf16 v23, v71, v38
    v_dot2c_f32_bf16 v16, v72, v39
    v_dot2c_f32_bf16 v17, v72, v40
    v_dot2c_f32_bf16 v18, v73, v39
    v_dot2c_f32_bf16 v19, v73, v40
    v_dot2c_f32_bf16 v20, v74, v39
    v_dot2c_f32_bf16 v21, v74, v40
    v_dot2c_f32_bf16 v22, v75, v39
    v_dot2c_f32_bf16 v23, v75, v40
    buffer_load_dwordx4 v[68:71], v32, s[28:31], 0 offen offset:2048 nt
    buffer_load_dwordx4 v[72:75], v32, s[28:31], 0 offen offset:3072 nt
    s_mov_b32 s37, s38
    s_add_u32 s34, s34, 1
    s_cmp_lt_u32 s37, 1024
    s_cbranch_scc1 L_loop
    v_and_b32 v1, 15, v0
    v_bfe_u32 v2, v0, 4, 2
    v_lshlrev_b32 v1, 5, v1
    v_permlane32_swap_b32 v16, v20
    v_permlane32_swap_b32 v17, v21
    v_permlane32_swap_b32 v18, v22
    v_permlane32_swap_b32 v19, v23
    v_add_f32_dpp v10, v10, v10 row_bcast:15 row_mask:0xa bank_mask:0xf
    v_add_f32 v16, v16, v20
    v_add_f32 v17, v17, v21
    v_add_f32 v18, v18, v22
    v_add_f32 v19, v19, v23
    v_add_f32_dpp v10, v10, v10 row_bcast:31 row_mask:0xc bank_mask:0xf
    v_lshl_add_u32 v1, v2, 3, v1
    v_permlane16_swap_b32 v16, v18
    v_permlane16_swap_b32 v17, v19
    s_lshl_b32 s3, s22, 9
    v_add_f32 v16, v16, v18
    v_add_f32 v17, v17, v19
    v_add_u32 v1, s3, v1
    s_lshl_b32 s3, s22, 3
    v_mov_b32 v2, s3
    ds_write_b64 v1, v[16:17]
    s_mov_b32 exec_lo, 0
    s_mov_b32 exec_hi, 0x80000000
    ds_write_b32 v2, v9 offset:1536
    ds_write_b32 v2, v10 offset:1540
    s_mov_b64 exec, -1
    s_waitcnt lgkmcnt(0)
    s_barrier
    s_cmp_lg_u32 s22, 0
    s_cbranch_scc1 L_end
    v_lshlrev_b32 v1, 3, v0
    v_mov_b32 v2, 0
    ds_read_b64 v[76:77], v1 offset:0
    ds_read_b64 v[78:79], v2 offset:1536
    ds_read_b64 v[80:81], v1 offset:512
    ds_read_b64 v[82:83], v2 offset:1544
    ds_read_b64 v[84:85], v1 offset:1024
    ds_read_b64 v[86:87], v2 offset:1552
    s_lshl_b32 s35, s23, 13
    v_add_u32 v3, s35, v36
    s_lshl_b32 s3, s36, 10
    v_add_u32 v2, s3, v3
    s_waitcnt lgkmcnt(0)
    v_max3_f32 v18, v78, v82, v86
    v_sub_f32 v78, v78, v18
    v_sub_f32 v82, v82, v18
    v_sub_f32 v86, v86, v18
    v_exp_f32 v78, v78
    v_exp_f32 v82, v82
    v_exp_f32 v86, v86
    s_nop 0
    v_mul_f32 v16, v76, v78
    v_mul_f32 v17, v77, v78
    v_mul_f32 v19, v79, v78
    v_fmac_f32 v16, v80, v82
    v_fmac_f32 v17, v81, v82
    v_fmac_f32 v19, v83, v82
    v_fmac_f32 v16, v84, v86
    v_fmac_f32 v17, v85, v86
    v_fmac_f32 v19, v87, v86
    s_cmp_eq_u32 s36, 0
    s_cbranch_scc1 L_owner
    global_store_dwordx4 v2, v[16:19], s[18:19] sc1
    s_endpgm
L_owner:
    v_add_u32 v2, 4096, v3
    v_mov_b32 v76, v16
    v_mov_b32 v77, v17
    v_mov_b32 v78, v18
    v_mov_b32 v79, v19
L_poll:
    global_load_dwordx4 v[80:83], v3, s[18:19] offset:1024 sc1
    global_load_dwordx4 v[84:87], v3, s[18:19] offset:2048 sc1
    global_load_dwordx4 v[88:91], v3, s[18:19] offset:3072 sc1
    global_load_dwordx4 v[92:95], v2, s[18:19] offset:0 sc1
    global_load_dwordx4 v[96:99], v2, s[18:19] offset:1024 sc1
    global_load_dwordx4 v[100:103], v2, s[18:19] offset:2048 sc1
    global_load_dwordx4 v[104:107], v2, s[18:19] offset:3072 sc1
L_pollwait:
    s_waitcnt vmcnt(0)
    v_min3_u32 v1, v83, v87, v91
    v_min3_u32 v1, v1, v95, v99
    v_min3_u32 v1, v1, v103, v107
    v_cmp_eq_u32 vcc, 0, v1
    s_cbranch_vccnz L_poll
    v_max3_f32 v18, v78, v82, v86
    v_max3_f32 v18, v18, v90, v94
    v_max3_f32 v18, v18, v98, v102
    v_max_f32 v18, v18, v106
    v_sub_f32 v78, v78, v18
    v_sub_f32 v82, v82, v18
    v_sub_f32 v86, v86, v18
    v_sub_f32 v90, v90, v18
    v_sub_f32 v94, v94, v18
    v_sub_f32 v98, v98, v18
    v_sub_f32 v102, v102, v18
    v_sub_f32 v106, v106, v18
    v_exp_f32 v78, v78
    v_exp_f32 v82, v82
    v_exp_f32 v86, v86
    v_exp_f32 v90, v90
    v_exp_f32 v94, v94
    v_exp_f32 v98, v98
    v_exp_f32 v102, v102
    v_exp_f32 v106, v106
    s_nop 0
    v_mul_f32 v16, v76, v78
    v_mul_f32 v17, v77, v78
    v_mul_f32 v19, v79, v78
    v_fmac_f32 v16, v80, v82
    v_fmac_f32 v17, v81, v82
    v_fmac_f32 v19, v83, v82
    v_fmac_f32 v16, v84, v86
    v_fmac_f32 v17, v85, v86
    v_fmac_f32 v19, v87, v86
    v_fmac_f32 v16, v88, v90
    v_fmac_f32 v17, v89, v90
    v_fmac_f32 v19, v91, v90
    v_fmac_f32 v16, v92, v94
    v_fmac_f32 v17, v93, v94
    v_fmac_f32 v19, v95, v94
    v_fmac_f32 v16, v96, v98
    v_fmac_f32 v17, v97, v98
    v_fmac_f32 v19, v99, v98
    v_fmac_f32 v16, v100, v102
    v_fmac_f32 v17, v101, v102
    v_fmac_f32 v19, v103, v102
    v_fmac_f32 v16, v104, v106
    v_fmac_f32 v17, v105, v106
    v_fmac_f32 v19, v107, v106
    v_rcp_f32 v19, v19
    s_lshl_b32 s3, s23, 8
    v_lshlrev_b32 v1, 2, v0
    v_mul_f32 v16, v16, v19
    v_mul_f32 v17, v17, v19
    v_add_u32 v1, s3, v1
    v_cvt_pk_bf16_f32 v16, v16, v17
    global_store_dword v1, v16, s[14:15]
L_end:
    s_endpgm
.section .rodata,"a"
.p2align 6
.amdhsa_kernel standalone__tree_speculative_verify_tree_attention_over_candidate_token_tree__decode_kernel
  .amdhsa_next_free_vgpr 108
  .amdhsa_next_free_sgpr 64
  .amdhsa_accum_offset 108
  .amdhsa_group_segment_fixed_size 0
  .amdhsa_kernarg_size 72
  .amdhsa_user_sgpr_count 2
  .amdhsa_user_sgpr_kernarg_segment_ptr 1
  .amdhsa_system_sgpr_workgroup_id_x 1
.end_amdhsa_kernel
```
